```python
import torch

def _softmax(x, axis=-1):
    return torch.softmax(x, dim=axis)
def _gelu(x):
    return torch.nn.functional.gelu(x, approximate="tanh")
def _silu(x):
    return torch.nn.functional.silu(x)
def _sigmoid(x):
    return torch.sigmoid(x)
def _layernorm(x, axis=-1, eps=1e-5):
    m = x.mean(dim=axis, keepdim=True)
    v = x.var(dim=axis, keepdim=True, unbiased=False)
    return (x - m) / torch.sqrt(v + eps)
def _scatter_add(tgt, idx, src, axis=0):
    return tgt.clone().index_add_(axis, idx, src)
def _segment_sum(src, seg, n):
    out = torch.zeros((n,) + src.shape[1:], dtype=src.dtype)
    return out.index_add_(0, seg, src)
def _pad(x, pw):
    flat = tuple(v for pair in reversed(pw) for v in pair)
    return torch.nn.functional.pad(x, flat)

kernel_name = 'gated_mix__compressed_kv_cla__dense_activation_mish__decode'

def setup_inputs():

    _w = (lambda a: (lambda t: t.to(torch.bfloat16) if t.is_floating_point() else t)(torch.as_tensor(a)))
    def _A_setup():
        B, H, Sq, Sk, D, M = 4, 32, 1, 4096, 128, 512
        Dc = 4 * D
        return {
            "x": _w((lambda *s: torch.randn(*s, dtype=torch.bfloat16) * 0.05)(B, Sq, M)),
            "c_kv": _w((lambda *s: torch.randn(*s, dtype=torch.bfloat16) * 0.4)(B, Sk, Dc)),
            "w_q": _w((lambda *s: torch.randn(*s, dtype=torch.bfloat16) * 12.8)(M, H, D) * (M ** -0.5)),
            "w_uk": _w((lambda *s: torch.randn(*s, dtype=torch.bfloat16) * 12.8)(Dc, H, D) * (Dc ** -0.5)),
            "w_uv": _w((lambda *s: torch.randn(*s, dtype=torch.bfloat16) * 0.4)(Dc, H, D) * (Dc ** -0.5)),
            "w_o": _w((lambda *s: torch.randn(*s, dtype=torch.bfloat16) * 0.4)(H, D, M) * ((H * D) ** -0.5)),
        }
    _A_in = _A_setup()

    def _B_setup():
        B, S, D, F = 4, 1, 512, 1376
        return {
            "x": _w((lambda *s: torch.randn(*s, dtype=torch.bfloat16) * 0.05)(B, S, D)),
            "w1": _w((lambda *s: torch.randn(*s, dtype=torch.bfloat16) * 12.8)(D, F) * (D ** -0.5)),
            "b1": _w((lambda *s: torch.randn(*s, dtype=torch.bfloat16) * 0.2)(F)),
            "w2": _w((lambda *s: torch.randn(*s, dtype=torch.bfloat16) * 0.05)(F, D) * (F ** -0.5)),
        }
    _B_in = _B_setup()

    return {
        "A_x": _A_in["x"],
        "A_c_kv": _A_in["c_kv"],
        "A_w_q": _A_in["w_q"],
        "A_w_uk": _A_in["w_uk"],
        "A_w_uv": _A_in["w_uv"],
        "A_w_o": _A_in["w_o"],
        "B_x": _B_in["x"],
        "B_w1": _B_in["w1"],
        "B_b1": _B_in["b1"],
        "B_w2": _B_in["w2"],
        "gate_w": _w((lambda *s: torch.randn(*s, dtype=torch.bfloat16) * 0.05)(512) * 16.0),
    }

def reference(A_x, A_c_kv, A_w_q, A_w_uk, A_w_uv, A_w_o, B_x, B_w1, B_b1, B_w2, gate_w):
    def _A_ref(x, c_kv, w_q, w_uk, w_uv, w_o):
        B, Sq, M = x.shape[0], x.shape[1], x.shape[2]
        Sk = c_kv.shape[1]
        H, D = w_q.shape[1], w_q.shape[2]
        q = torch.einsum("bqm,mhd->bhqd", x, w_q)
        k = torch.einsum("bkc,chd->bhkd", c_kv, w_uk)
        v = torch.einsum("bkc,chd->bhkd", c_kv, w_uv)
        scores = torch.einsum("bhqd,bhkd->bhqk", q, k) * (D ** -0.5)
        off = Sk - Sq
        qi = torch.arange(Sq)[:, None]
        kj = torch.arange(Sk)[None, :]
        cmask = kj <= (qi + off)
        scores = torch.where(cmask[None, None], scores, -1e9)
        p = _softmax(scores, axis=-1)
        ctx = torch.einsum("bhqk,bhkd->bhqd", p, v)
        return torch.einsum("bhqd,hdm->bqm", ctx, w_o)

    def _B_ref(x, w1, b1, w2):
        h = torch.einsum("bsd,df->bsf", x, w1) + b1
        sp = torch.log1p(torch.exp(-torch.abs(h))) + torch.where(h > 0, h, torch.zeros_like(h))
        act = h * torch.tanh(sp)
        return torch.einsum("bsf,fd->bsd", act, w2)

    x = A_x
    g = _sigmoid((x * gate_w).sum(-1, keepdims=True))
    a = _A_ref(x, A_c_kv, A_w_q, A_w_uk, A_w_uv, A_w_o)
    b = _B_ref(x, B_w1, B_b1, B_w2)
    return g * a + (1 - g) * b
```

```asm
; @launch grid=(256,1,1) block=(512,1,1) lds=163840
.amdgcn_target "amdgcn-amd-amdhsa--gfx950"
.text
.globl gated_mix__compressed_kv_cla__dense_activation_mish__decode_kernel
.p2align 8
.type gated_mix__compressed_kv_cla__dense_activation_mish__decode_kernel,@function
gated_mix__compressed_kv_cla__dense_activation_mish__decode_kernel:
    s_cmp_ge_u32 s2, 256
    s_cbranch_scc1 L_end
    s_getpc_b64 s[70:71]
L_pf:
    v_lshlrev_b32 v4, 5, v0
    v_min_u32 v4, L_end-L_pf, v4
    global_load_dword v254, v4, s[70:71]
    s_load_dwordx2 s[4:5], s[0:1], 0
    s_load_dwordx2 s[12:13], s[0:1], 16
    s_load_dwordx2 s[8:9], s[0:1], 8
    s_load_dwordx2 s[36:37], s[0:1], 104
    s_load_dwordx2 s[16:17], s[0:1], 24
    s_load_dwordx2 s[28:29], s[0:1], 56
    s_load_dwordx2 s[40:41], s[0:1], 80
    s_load_dwordx2 s[44:45], s[0:1], 64
    s_load_dwordx2 s[24:25], s[0:1], 40
    s_load_dwordx2 s[32:33], s[0:1], 72
    s_load_dwordx2 s[20:21], s[0:1], 32
    s_load_dwordx2 s[48:49], s[0:1], 88
    v_lshrrev_b32 v4, 6, v0
    v_and_b32 v1, 63, v0
    v_readfirstlane_b32 s59, v4
    v_and_b32 v2, 15, v0
    v_bfe_u32 v3, v0, 4, 2
    v_lshlrev_b32 v10, 4, v1
    s_and_b32 s70, s2, 7
    s_lshr_b32 s71, s2, 3
    s_bfe_u32 s64, s71, 0x10001
    s_lshr_b32 s61, s71, 2
    s_and_b32 s72, s71, 1
    s_lshl_b32 s60, s64, 3
    s_add_u32 s60, s60, s70
    s_lshl_b32 s60, s60, 1
    s_add_u32 s60, s60, s72
    s_mov_b32 s6, 4096
    s_mov_b32 s7, 0x20000
    s_mov_b32 s14, 4194304
    s_mov_b32 s15, 0x20000
    s_mov_b32 s10, 16777216
    s_mov_b32 s11, 0x20000
    s_mov_b32 s38, 268435456
    s_mov_b32 s39, 0x20000
    s_mov_b32 s18, 4194304
    s_mov_b32 s19, 0x20000
    s_mov_b32 s30, 1409024
    s_mov_b32 s31, 0x20000
    s_lshl_b32 s73, s64, 1
    s_add_u32 s73, s73, s72
    s_lshl_b32 s54, s73, 3
    s_add_u32 s54, s54, s70
    s_cmp_lt_u32 s54, 22
    s_cselect_b32 s55, 1, 0
    s_lshr_b32 s62, s70, 1
    s_and_b32 s73, s70, 1
    s_lshl_b32 s73, s73, 3
    s_add_u32 s73, s73, s61
    s_lshl_b32 s73, s73, 1
    s_add_u32 s63, s73, s72
    s_lshl_b32 s52, s60, 3
    s_add_u32 s52, s52, s61
    s_lshl_b32 s52, s52, 14
    s_add_u32 s52, s52, 2097152
    v_mov_b32 v248, -1
    v_mov_b32 v249, -1
    v_mov_b32 v250, -1
    v_mov_b32 v251, -1
    v_mov_b32 v6, 0
    s_cmp_ge_u32 s59, 4
    s_cbranch_scc1 L_loader
    s_lshl_b32 s71, s60, 8
    v_bfe_u32 v4, v1, 4, 1
    v_lshlrev_b32 v4, 1, v4
    v_and_b32 v5, 7, v1
    v_xor_b32 v4, v4, v5
    v_xor_b32 v5, 4, v4
    v_lshlrev_b32 v4, 4, v4
    v_lshlrev_b32 v5, 4, v5
    v_lshrrev_b32 v6, 3, v1
    v_lshl_add_u32 v8, v6, 13, v4
    v_lshl_add_u32 v9, v6, 13, v5
    v_mul_u32_u24 v6, 2752, v6
    v_add_u32 v4, v6, v4
    v_add_u32 v11, v6, v5
    s_lshr_b32 s73, s61, 1
    s_lshl_b32 s73, s73, 2
    s_add_u32 s73, s73, s59
    s_lshl_b32 s73, s73, 18
    s_and_b32 s74, s61, 1
    s_lshl_b32 s74, s74, 7
    s_add_u32 s73, s73, s74
    s_add_u32 s73, s73, s71
    s_lshl_b32 s74, s59, 12
    s_add_u32 m0, s74, 135168
    s_waitcnt lgkmcnt(0)
    buffer_load_dwordx4 v8, s[12:15], s73 offen nt lds
    s_add_u32 s73, s73, 65536
    s_add_u32 m0, m0, 1024
    s_nop 0
    buffer_load_dwordx4 v9, s[12:15], s73 offen nt lds
    s_add_u32 s73, s73, 65536
    s_add_u32 m0, m0, 1024
    s_nop 0
    buffer_load_dwordx4 v8, s[12:15], s73 offen nt lds
    s_add_u32 s73, s73, 65536
    s_add_u32 m0, m0, 1024
    s_nop 0
    buffer_load_dwordx4 v9, s[12:15], s73 offen nt lds
    s_lshl_b32 s73, s59, 10
    s_add_u32 m0, s73, 151552
    s_load_dword s65, s[36:37], 0
    buffer_load_dwordx4 v10, s[4:7], s73 offen lds
    v_lshlrev_b32 v12, 2, v3
    v_xor_b32 v12, v12, v2
    v_lshlrev_b32 v12, 4, v12
    v_lshl_add_u32 v12, v3, 13, v12
    s_lshl_b32 s72, s61, 2
    s_add_u32 s72, s72, s59
    s_lshl_b32 s72, s72, 17
    s_add_u32 s72, s72, s71
    s_mul_i32 s73, s59, 4224
    s_add_u32 m0, s73, 118272
    s_nop 0
    buffer_load_dwordx4 v12, s[16:19], s72 offen nt lds
    s_add_u32 s72, s72, 32768
    s_add_u32 m0, m0, 1056
    s_nop 0
    buffer_load_dwordx4 v12, s[16:19], s72 offen nt lds
    s_add_u32 s72, s72, 32768
    s_add_u32 m0, m0, 1056
    s_nop 0
    buffer_load_dwordx4 v12, s[16:19], s72 offen nt lds
    s_add_u32 s72, s72, 32768
    s_add_u32 m0, m0, 1056
    s_nop 0
    buffer_load_dwordx4 v12, s[16:19], s72 offen nt lds
    s_cmp_lg_u32 s59, 0
    s_cbranch_scc1 L_noflaginit
    v_bfe_u32 v12, v1, 3, 2
    v_mul_u32_u24 v12, 1056, v12
    v_and_b32 v13, 7, v1
    v_lshl_add_u32 v12, v13, 2, v12
    v_add_u32 v12, 131968, v12
    ds_write_b32 v12, v248
    s_waitcnt lgkmcnt(0)
L_noflaginit:
    s_barrier
    s_branch L_hrest
L_loader:
    s_sub_u32 s53, s59, 4
    s_lshl_b32 s70, s62, 22
    s_lshl_b32 s73, s63, 17
    s_add_u32 s70, s70, s73
    s_lshl_b32 s73, s53, 15
    s_add_u32 s70, s70, s73
    s_add_u32 s74, s70, 32768
    s_mul_i32 s73, s53, 33792
    s_add_u32 m0, s73, 0
    v_subrev_u32 v12, 256, v0
    v_lshlrev_b32 v12, 4, v12
    s_lshl_b32 s72, s60, 10
    s_lshl_b32 s73, s61, 7
    s_add_u32 s72, s72, s73
    s_lshl_b32 s73, s53, 5
    s_add_u32 s72, s72, s73
    s_add_u32 s75, s72, 393216
    s_mov_b32 s72, s52
    s_waitcnt lgkmcnt(0)
    s_load_dword s65, s[36:37], 0
    buffer_load_dwordx4 v10, s[8:11], s70 offen nt lds
    s_add_u32 m0, m0, 1056
    s_add_u32 s70, s70, 1024
    s_waitcnt lgkmcnt(0)
    s_add_u32 s65, s65, 0x9e3779b9
    s_add_u32 s73, s65, 0x9e3779b9
    s_cmp_eq_u32 s65, -1
    s_cselect_b32 s65, s73, s65
    v_mov_b32 v14, 134096
    buffer_load_dwordx4 v10, s[8:11], s70 offen nt lds
    s_add_u32 m0, m0, 1056
    s_add_u32 s70, s70, 1024
    buffer_load_dwordx4 v10, s[8:11], s70 offen nt lds
    s_add_u32 m0, m0, 1056
    s_add_u32 s70, s70, 1024
    buffer_load_dwordx4 v10, s[8:11], s70 offen nt lds
    s_add_u32 m0, m0, 1056
    s_add_u32 s70, s70, 1024
    s_barrier
    buffer_load_dwordx4 v10, s[8:11], s70 offen nt lds
    s_add_u32 m0, m0, 1056
    s_add_u32 s70, s70, 1024
    buffer_load_dwordx4 v10, s[8:11], s70 offen nt lds
    s_add_u32 m0, m0, 1056
    s_add_u32 s70, s70, 1024
    buffer_load_dwordx4 v10, s[8:11], s70 offen nt lds
    s_add_u32 m0, m0, 1056
    s_add_u32 s70, s70, 1024
    buffer_load_dwordx4 v10, s[8:11], s70 offen nt lds
    s_add_u32 m0, m0, 1056
    s_add_u32 s70, s70, 1024
    s_waitcnt vmcnt(7)
    buffer_load_dwordx4 v10, s[8:11], s70 offen nt lds
    s_add_u32 m0, m0, 1056
    s_add_u32 s70, s70, 1024
    s_waitcnt vmcnt(7)
    buffer_load_dwordx4 v10, s[8:11], s70 offen nt lds
    s_add_u32 m0, m0, 1056
    s_add_u32 s70, s70, 1024
    s_waitcnt vmcnt(7)
    buffer_load_dwordx4 v10, s[8:11], s70 offen nt lds
    s_add_u32 m0, m0, 1056
    s_add_u32 s70, s70, 1024
    s_waitcnt vmcnt(7)
    buffer_load_dwordx4 v10, s[8:11], s70 offen nt lds
    s_add_u32 m0, m0, 1056
    s_add_u32 s70, s70, 1024
    s_waitcnt vmcnt(7)
    buffer_store_dwordx4 v[248:251], v12, s[36:39], s72 offen sc1
    s_waitcnt vmcnt(7)
    buffer_load_dwordx4 v10, s[8:11], s70 offen nt lds
    s_add_u32 m0, m0, 1056
    s_add_u32 s70, s70, 1024
    s_waitcnt vmcnt(7)
    buffer_load_dwordx4 v10, s[8:11], s70 offen nt lds
    s_add_u32 m0, m0, 1056
    s_add_u32 s70, s70, 1024
    s_waitcnt vmcnt(7)
    s_add_u32 s72, s72, 4096
    buffer_store_dwordx4 v[248:251], v12, s[36:39], s72 offen sc1
    s_waitcnt vmcnt(7)
    buffer_load_dwordx4 v10, s[8:11], s70 offen nt lds
    s_add_u32 m0, m0, 1056
    s_add_u32 s70, s70, 1024
    s_waitcnt vmcnt(7)
    buffer_load_dwordx4 v10, s[8:11], s70 offen nt lds
    s_add_u32 m0, m0, 1056
    s_add_u32 s70, s70, 1024
    s_waitcnt vmcnt(7)
    s_add_u32 s72, s72, 4096
    buffer_store_dwordx4 v[248:251], v12, s[36:39], s72 offen sc1
    s_cmp_lg_u32 s59, 7
    s_cbranch_scc1 L_nogate7
    v_mov_b32 v15, 131968
    s_mov_b32 s3, 0
L_gate7:
    ds_read_b128 v[84:87], v15
    s_waitcnt lgkmcnt(0)
    v_xor_b32 v84, s65, v84
    v_xor_b32 v85, s65, v85
    v_or_b32 v84, v84, v85
    v_xor_b32 v86, s65, v86
    v_or_b32 v84, v84, v86
    v_xor_b32 v87, s65, v87
    v_or_b32 v84, v84, v87
    v_cmp_ne_u32 vcc, 0, v84
    s_cbranch_vccz L_nogate7
    s_add_u32 s3, s3, 1
    s_cmp_gt_u32 s3, 320000
    s_cbranch_scc1 L_nogate7
    s_sleep 1
    s_branch L_gate7
L_nogate7:
    s_waitcnt vmcnt(7)
    buffer_load_dwordx4 v10, s[8:11], s70 offen nt lds
    s_add_u32 m0, m0, 1056
    s_add_u32 s70, s70, 1024
    s_waitcnt vmcnt(7)
    buffer_load_dwordx4 v10, s[8:11], s70 offen nt lds
    s_add_u32 m0, m0, 1056
    s_add_u32 s70, s70, 1024
    s_waitcnt vmcnt(7)
    s_add_u32 s72, s72, 4096
    buffer_store_dwordx4 v[248:251], v12, s[36:39], s72 offen sc1
    s_waitcnt vmcnt(7)
    buffer_load_dwordx4 v10, s[8:11], s70 offen nt lds
    s_add_u32 m0, m0, 1056
    s_add_u32 s70, s70, 1024
    s_waitcnt vmcnt(7)
    buffer_load_dwordx4 v10, s[8:11], s70 offen nt lds
    s_add_u32 m0, m0, 1056
    s_add_u32 s70, s70, 1024
    s_waitcnt vmcnt(7)
    s_mov_b64 exec, 3
    buffer_store_dwordx4 v[248:251], v10, s[36:39], s75 offen sc1
    s_mov_b64 exec, -1
    s_waitcnt vmcnt(7)
    buffer_load_dwordx4 v10, s[8:11], s70 offen nt lds
    s_add_u32 m0, m0, 1056
    s_add_u32 s70, s70, 1024
    s_waitcnt vmcnt(7)
    buffer_load_dwordx4 v10, s[8:11], s70 offen nt lds
    s_add_u32 m0, m0, 1056
    s_add_u32 s70, s70, 1024
    s_waitcnt vmcnt(7)
    buffer_load_dwordx4 v10, s[8:11], s70 offen nt lds
    s_add_u32 m0, m0, 1056
    s_add_u32 s70, s70, 1024
    s_waitcnt vmcnt(7)
    buffer_load_dwordx4 v10, s[8:11], s70 offen nt lds
    s_add_u32 m0, m0, 1056
    s_add_u32 s70, s70, 1024
    s_lshl_b32 s73, s53, 2
    s_add_u32 s73, s73, 135152
    v_mov_b32 v13, s73
    v_mov_b32 v14, s65
    s_waitcnt vmcnt(4)
    ds_write_b32 v13, v14
    s_cmp_lg_u32 s59, 4
    s_cbranch_scc1 L_noann
    v_mov_b32 v12, 135152
    s_mov_b32 s3, 0
L_clrsync:
    ds_read_b128 v[84:87], v12
    s_waitcnt lgkmcnt(0)
    v_xor_b32 v84, s65, v84
    v_xor_b32 v85, s65, v85
    v_or_b32 v84, v84, v85
    v_xor_b32 v86, s65, v86
    v_or_b32 v84, v84, v86
    v_xor_b32 v87, s65, v87
    v_or_b32 v84, v84, v87
    v_cmp_ne_u32 vcc, 0, v84
    s_cbranch_vccz L_clrann
    s_add_u32 s3, s3, 1
    s_cmp_gt_u32 s3, 320000
    s_cbranch_scc0 L_clrsync
L_clrann:
    s_lshl_b32 s72, s60, 3
    s_add_u32 s72, s72, s61
    s_lshl_b32 s72, s72, 2
    s_add_u32 s72, s72, 425984
    v_mov_b32 v12, 0
    v_mov_b32 v13, s65
    s_mov_b64 exec, 1
    buffer_store_dword v13, v12, s[36:39], s72 offen sc1
    s_mov_b64 exec, -1
L_noann:
    s_waitcnt vmcnt(7)
    buffer_load_dwordx4 v10, s[8:11], s70 offen nt lds
    s_add_u32 m0, m0, 1056
    s_add_u32 s70, s70, 1024
    s_waitcnt vmcnt(7)
    buffer_load_dwordx4 v10, s[8:11], s70 offen nt lds
    s_add_u32 m0, m0, 1056
    s_add_u32 s70, s70, 1024
    s_waitcnt vmcnt(7)
    buffer_load_dwordx4 v10, s[8:11], s70 offen nt lds
    s_add_u32 m0, m0, 1056
    s_add_u32 s70, s70, 1024
    s_waitcnt vmcnt(7)
    buffer_load_dwordx4 v10, s[8:11], s70 offen nt lds
    s_add_u32 m0, m0, 1056
    s_add_u32 s70, s70, 1024
    s_waitcnt vmcnt(7)
    buffer_load_dwordx4 v10, s[8:11], s70 offen nt lds
    s_add_u32 m0, m0, 1056
    s_add_u32 s70, s70, 1024
    s_waitcnt vmcnt(7)
    buffer_load_dwordx4 v10, s[8:11], s70 offen nt lds
    s_add_u32 m0, m0, 1056
    s_add_u32 s70, s70, 1024
    s_waitcnt vmcnt(7)
    buffer_load_dwordx4 v10, s[8:11], s70 offen nt lds
    s_add_u32 m0, m0, 1056
    s_add_u32 s70, s70, 1024
    s_waitcnt vmcnt(7)
    buffer_load_dwordx4 v10, s[8:11], s70 offen nt lds
    s_add_u32 m0, m0, 1056
    s_add_u32 s70, s70, 1024
L_ckv_done:
    s_branch L_join
L_hrest:
    s_lshl_b32 s72, s60, 11
    s_lshl_b32 s73, s61, 8
    s_add_u32 s72, s72, s73
    s_lshl_b32 s73, s59, 6
    s_add_u32 s72, s72, s73
    s_add_u32 s72, s72, 131072
    v_lshlrev_b32 v7, 16, v2
    v_lshl_add_u32 v7, v3, 4, v7
    v_add_u32 v7, s72, v7
    v_and_b32 v6, 1, v3
    v_lshlrev_b32 v6, 10, v6
    v_lshrrev_b32 v5, 1, v3
    v_lshl_add_u32 v6, v5, 8, v6
    v_lshl_add_u32 v6, v2, 4, v6
    s_and_b32 s73, s61, 1
    s_lshl_b32 s73, s73, 1
    s_lshr_b32 s72, s59, 1
    s_add_u32 s73, s73, s72
    s_lshl_b32 s73, s73, 11
    s_lshl_b32 s74, s60, 13
    s_add_u32 s74, s74, s73
    s_and_b32 s73, s59, 1
    s_lshl_b32 s73, s73, 9
    s_add_u32 s74, s74, s73
    s_lshr_b32 s73, s61, 1
    s_lshl_b32 s73, s73, 6
    s_add_u32 s74, s74, s73
    s_add_u32 s74, s74, 1572864
    v_lshlrev_b32 v5, 6, v3
    v_lshl_add_u32 v5, v2, 4, v5
    s_lshl_b32 s53, s60, 3
    s_add_u32 s53, s53, s61
    s_lshl_b32 s53, s53, 10
    s_lshl_b32 s72, s59, 8
    s_add_u32 s53, s53, s72
    s_add_u32 s53, s53, 1310720
    s_mov_b32 exec_lo, 0x000f000f
    s_mov_b32 exec_hi, 0x000f000f
    s_mov_b64 exec, -1
    s_mov_b32 s56, s74
    s_add_u32 s74, s74, 5242880
    s_lshl_b32 s72, s60, 13
    s_lshl_b32 s73, s59, 11
    s_add_u32 s72, s72, s73
    s_add_u32 s72, s72, 6815744
    v_bfe_u32 v14, v2, 3, 1
    v_and_b32 v15, 1, v3
    v_lshl_add_u32 v14, v15, 1, v14
    v_lshlrev_b32 v14, 5, v14
    s_lshl_b32 s72, s59, 5
    v_xor_b32 v14, s72, v14
    v_lshrrev_b32 v15, 2, v2
    v_lshl_add_u32 v15, v3, 3, v15
    v_lshl_add_u32 v14, v15, 7, v14
    v_bfe_u32 v15, v2, 1, 1
    v_lshl_add_u32 v14, v15, 4, v14
    v_and_b32 v15, 1, v2
    v_lshl_add_u32 v14, v15, 3, v14
    v_add_u32 v16, 135168, v14
    v_add_u32 v17, 155648, v14
    v_and_b32 v14, 3, v2
    v_lshlrev_b32 v14, 10, v14
    v_lshl_add_u32 v14, v3, 4, v14
    s_lshr_b32 s73, s61, 1
    s_lshl_b32 s73, s73, 8
    s_add_u32 s73, s73, 151552
    v_add_u32 v18, s73, v14
    s_lshl_b32 s73, s61, 7
    s_add_u32 s73, s73, 151552
    v_add_u32 v19, s73, v14
    s_waitcnt lgkmcnt(0)
    s_add_u32 s65, s65, 0x9e3779b9
    s_add_u32 s72, s65, 0x9e3779b9
    s_cmp_eq_u32 s65, -1
    s_cselect_b32 s65, s72, s65
    s_lshl_b32 s72, s59, 2
    s_add_u32 s72, s72, 134080
    v_mov_b32 v12, s72
    v_mov_b32 v13, s65
    s_waitcnt vmcnt(4)
    ds_write_b32 v12, v13
    v_mov_b32 v12, 134080
    s_mov_b32 s3, 0
L_hsync:
    ds_read_b128 v[84:87], v12
    s_waitcnt lgkmcnt(0)
    v_xor_b32 v84, s65, v84
    v_xor_b32 v85, s65, v85
    v_or_b32 v84, v84, v85
    v_xor_b32 v86, s65, v86
    v_or_b32 v84, v84, v86
    v_xor_b32 v87, s65, v87
    v_or_b32 v84, v84, v87
    v_cmp_ne_u32 vcc, 0, v84
    s_cbranch_vccz L_hsynced
    s_add_u32 s3, s3, 1
    s_cmp_gt_u32 s3, 320000
    s_cbranch_scc0 L_hsync
L_hsynced:
    ds_read_b128 v[148:151], v18 offset:0
    ds_read_b64_tr_b16 v[20:21], v16 offset:0
    ds_read_b64_tr_b16 v[22:23], v16 offset:512
    ds_read_b128 v[152:155], v18 offset:64
    ds_read_b64_tr_b16 v[24:25], v16 offset:4096
    ds_read_b64_tr_b16 v[26:27], v16 offset:4608
    ds_read_b128 v[156:159], v18 offset:128
    ds_read_b64_tr_b16 v[28:29], v16 offset:8192
    ds_read_b64_tr_b16 v[30:31], v16 offset:8704
    ds_read_b128 v[160:163], v18 offset:192
    ds_read_b64_tr_b16 v[32:33], v16 offset:12288
    ds_read_b64_tr_b16 v[34:35], v16 offset:12800
    v_mov_b32 v90, s65
    v_mov_b32 v91, s65
    s_mul_i32 s72, s59, 4224
    s_add_u32 s72, s72, 118272
    v_lshrrev_b32 v12, 2, v2
    v_mul_u32_u24 v12, 1056, v12
    v_and_b32 v13, 3, v2
    v_lshl_add_u32 v12, v13, 8, v12
    v_lshl_add_u32 v12, v3, 4, v12
    v_add_u32 v12, s72, v12
    v_lshlrev_b32 v13, 6, v13
    s_waitcnt lgkmcnt(9)
    v_mfma_f32_16x16x32_bf16 v[228:231], v[20:23], v[148:151], 0
    s_waitcnt lgkmcnt(6)
    v_mfma_f32_16x16x32_bf16 v[228:231], v[24:27], v[152:155], v[228:231]
    s_waitcnt lgkmcnt(3)
    v_mfma_f32_16x16x32_bf16 v[228:231], v[28:31], v[156:159], v[228:231]
    s_waitcnt lgkmcnt(0)
    v_mfma_f32_16x16x32_bf16 v[228:231], v[32:35], v[160:163], v[228:231]
    s_nop 7
    v_cvt_pk_bf16_f32 v88, v228, v229
    v_cvt_pk_bf16_f32 v89, v230, v231
    s_mov_b32 exec_lo, 0x000f000f
    s_mov_b32 exec_hi, 0x000f000f
    buffer_store_dwordx4 v[88:91], v6, s[36:39], s74 offen
    s_mov_b64 exec, -1
    s_lshl_b32 s73, s60, 13
    s_lshl_b32 s72, s59, 11
    s_add_u32 s73, s73, s72
    s_add_u32 s73, s73, 6815744
    s_waitcnt vmcnt(0)
    buffer_load_dwordx4 v[20:23], v10, s[36:39], s73 offen offset:0 sc1
    buffer_load_dwordx4 v[24:27], v10, s[36:39], s73 offen offset:1024 sc1
    s_waitcnt vmcnt(2)
    v_xor_b32 v14, 0, v13
    v_add_u32 v14, v14, v12
    ds_read_b128 v[116:119], v14
    v_xor_b32 v14, 64, v13
    v_add_u32 v14, v14, v12
    ds_read_b128 v[120:123], v14
    v_xor_b32 v14, 128, v13
    v_add_u32 v14, v14, v12
    ds_read_b128 v[124:127], v14
    v_xor_b32 v14, 192, v13
    v_add_u32 v14, v14, v12
    ds_read_b128 v[128:131], v14
    s_lshl_b32 s72, s59, 2
    s_add_u32 s72, s72, 131968
    v_mov_b32 v12, s72
    v_mov_b32 v13, s65
    s_lshl_b32 s72, s59, 10
    s_add_u32 s72, s72, 159744
    v_add_u32 v15, s72, v10
    s_waitcnt lgkmcnt(0)
    ds_write_b32 v12, v13
    s_mov_b32 s3, 0
L_qcheck:
    s_waitcnt vmcnt(0)
    v_cmp_ne_u32 s[76:77], s65, v22
    v_cmp_ne_u32 s[78:79], s65, v26
    s_or_b64 vcc, s[76:77], s[78:79]
    s_cbranch_scc0 L_qok
    s_add_u32 s3, s3, 1
    s_cmp_gt_u32 s3, 20000
    s_cbranch_scc1 L_qok
    s_cmp_lt_u32 s3, 6
    s_cbranch_scc1 L_qagain
    s_cmp_lg_u32 s3, 6
    s_cbranch_scc1 L_qflip
    s_mov_b32 exec_lo, 0x000f000f
    s_mov_b32 exec_hi, 0x000f000f
    buffer_store_dwordx4 v[88:91], v6, s[36:39], s56 offen sc1
    s_mov_b64 exec, -1
L_qflip:
    s_xor_b32 s73, s73, 7340032
    s_sleep 1
L_qagain:
    buffer_load_dwordx4 v[20:23], v10, s[36:39], s73 offen offset:0 sc1
    buffer_load_dwordx4 v[24:27], v10, s[36:39], s73 offen offset:1024 sc1
    s_branch L_qcheck
L_qok:
    s_cmp_ge_u32 s3, 6
    s_cbranch_scc1 L_qsdone
    s_mov_b32 exec_lo, 0x000f000f
    s_mov_b32 exec_hi, 0x000f000f
    buffer_store_dwordx4 v[88:91], v6, s[36:39], s56 offen sc1
    s_mov_b64 exec, -1
L_qsdone:
    ds_write_b64 v15, v[20:21]
    ds_write_b64 v15, v[24:25] offset:8
    s_lshl_b32 s72, s59, 2
    s_add_u32 s72, s72, 133040
    v_mov_b32 v12, s72
    v_mov_b32 v13, s65
    s_waitcnt lgkmcnt(0)
    ds_write_b32 v12, v13
    v_mov_b32 v12, 133040
    s_mov_b32 s3, 0
L_qsync:
    ds_read_b128 v[96:99], v12
    s_waitcnt lgkmcnt(0)
    v_xor_b32 v96, s65, v96
    v_xor_b32 v97, s65, v97
    v_or_b32 v96, v96, v97
    v_xor_b32 v98, s65, v98
    v_or_b32 v96, v96, v98
    v_xor_b32 v99, s65, v99
    v_or_b32 v96, v96, v99
    v_cmp_ne_u32 vcc, 0, v96
    s_cbranch_vccz L_qsync_ok
    s_add_u32 s3, s3, 1
    s_cmp_gt_u32 s3, 320000
    s_cbranch_scc0 L_qsync
L_qsync_ok:
    v_add_u32 v12, 159744, v10
    ds_read_b128 v[20:23], v12 offset:0
    ds_read_b128 v[28:31], v12 offset:1024
    ds_read_b128 v[36:39], v12 offset:2048
    ds_read_b128 v[44:47], v12 offset:3072
    s_lshl_b32 s72, s59, 2
    s_add_u32 s72, s72, 134096
    v_mov_b32 v12, s72
    s_waitcnt lgkmcnt(0)
    ds_write_b32 v12, v13
    s_mov_b32 s73, 0x3e0293ee
    v_mfma_f32_16x16x32_bf16 v[228:231], v[116:119], v[20:23], 0
    v_mfma_f32_16x16x32_bf16 v[228:231], v[120:123], v[28:31], v[228:231]
    v_mfma_f32_16x16x32_bf16 v[228:231], v[124:127], v[36:39], v[228:231]
    v_mfma_f32_16x16x32_bf16 v[228:231], v[128:131], v[44:47], v[228:231]
    v_mov_b32 v250, s65
    v_mov_b32 v251, s65
    s_nop 5
    v_add_f32_dpp v228, v228, v228 row_ror:4 row_mask:0xf bank_mask:0xf
    v_add_f32_dpp v229, v229, v229 row_ror:4 row_mask:0xf bank_mask:0xf
    v_add_f32_dpp v230, v230, v230 row_ror:4 row_mask:0xf bank_mask:0xf
    v_add_f32_dpp v231, v231, v231 row_ror:4 row_mask:0xf bank_mask:0xf
    v_add_f32_dpp v228, v228, v228 row_ror:8 row_mask:0xf bank_mask:0xf
    v_add_f32_dpp v229, v229, v229 row_ror:8 row_mask:0xf bank_mask:0xf
    v_add_f32_dpp v230, v230, v230 row_ror:8 row_mask:0xf bank_mask:0xf
    v_add_f32_dpp v231, v231, v231 row_ror:8 row_mask:0xf bank_mask:0xf
    v_mul_f32 v228, s73, v228
    v_mul_f32 v229, s73, v229
    v_mul_f32 v230, s73, v230
    v_mul_f32 v231, s73, v231
    v_cvt_pk_bf16_f32 v248, v228, v229
    v_cvt_pk_bf16_f32 v249, v230, v231
    s_mov_b32 exec_lo, 0x000f000f
    s_mov_b32 exec_hi, 0x000f000f
    buffer_store_dwordx4 v[248:251], v7, s[36:39], 0 offen sc1
    s_mov_b64 exec, -1
    v_mov_b32 v12, 134096
    s_mov_b32 s3, 0
L_qbfree:
    ds_read_b128 v[96:99], v12
    s_waitcnt lgkmcnt(0)
    v_xor_b32 v96, s65, v96
    v_xor_b32 v97, s65, v97
    v_or_b32 v96, v96, v97
    v_xor_b32 v98, s65, v98
    v_or_b32 v96, v96, v98
    v_xor_b32 v99, s65, v99
    v_or_b32 v96, v96, v99
    v_cmp_ne_u32 vcc, 0, v96
    s_cbranch_vccz L_qbfree_ok
    s_add_u32 s3, s3, 1
    s_cmp_gt_u32 s3, 320000
    s_cbranch_scc0 L_qbfree
L_qbfree_ok:
    s_mov_b32 s42, 1024
    s_mov_b32 s43, 0x20000
    buffer_load_dwordx4 v[88:91], v10, s[40:43], 0 offen
    s_lshl_b32 s73, s61, 2
    s_add_u32 s73, s73, s59
    s_mul_i32 s73, s73, 44032
    s_lshl_b32 s74, s54, 7
    s_add_u32 s73, s73, s74
    s_cmp_eq_u32 s55, 0
    s_cselect_b32 s73, 0x7ff00000, s73
    s_lshl_b32 s74, s59, 11
    s_add_u32 m0, s74, 155648
    v_mov_b32 v84, -1
    v_mov_b32 v85, -1
    v_mov_b32 v86, -1
    v_mov_b32 v87, -1
    buffer_load_dwordx4 v4, s[28:31], s73 offen nt lds
    s_add_u32 s73, s73, 22016
    s_add_u32 m0, m0, 1024
    s_nop 0
    buffer_load_dwordx4 v11, s[28:31], s73 offen nt lds
    s_waitcnt vmcnt(0)
    s_lshl_b32 s72, s59, 2
    s_add_u32 s72, s72, 133024
    v_mov_b32 v12, s72
    v_mov_b32 v13, s65
    ds_write_b32 v12, v13
    v_mov_b32 v12, 133024
    s_mov_b32 s3, 0
L_w1sync:
    ds_read_b128 v[84:87], v12
    s_waitcnt lgkmcnt(0)
    v_xor_b32 v84, s65, v84
    v_xor_b32 v85, s65, v85
    v_or_b32 v84, v84, v85
    v_xor_b32 v86, s65, v86
    v_or_b32 v84, v84, v86
    v_xor_b32 v87, s65, v87
    v_or_b32 v84, v84, v87
    v_cmp_ne_u32 vcc, 0, v84
    s_cbranch_vccz L_w1synced
    s_add_u32 s3, s3, 1
    s_cmp_gt_u32 s3, 320000
    s_cbranch_scc0 L_w1sync
L_w1synced:
    ds_read_b128 v[148:151], v19 offset:0
    ds_read_b64_tr_b16 v[20:21], v17 offset:0
    ds_read_b64_tr_b16 v[22:23], v17 offset:512
    ds_read_b128 v[152:155], v19 offset:64
    ds_read_b64_tr_b16 v[24:25], v17 offset:4096
    ds_read_b64_tr_b16 v[26:27], v17 offset:4608
    s_mov_b32 s76, 0x7060500
    s_mov_b32 s77, 0x7060501
    s_mov_b32 s78, 0x7060502
    s_mov_b32 s79, 0x7060503
    v_mov_b32 v253, s65
    s_waitcnt lgkmcnt(3)
    v_mfma_f32_16x16x32_bf16 v[228:231], v[20:23], v[148:151], 0
    s_waitcnt lgkmcnt(0)
    v_mfma_f32_16x16x32_bf16 v[228:231], v[24:27], v[152:155], v[228:231]
    s_nop 7
    v_perm_b32 v84, v228, v253, s76
    v_perm_b32 v85, v229, v253, s77
    v_perm_b32 v86, v230, v253, s78
    v_perm_b32 v87, v231, v253, s79
    s_mov_b32 exec_lo, 0x000f000f
    s_mov_b32 exec_hi, 0x000f000f
    buffer_store_dwordx4 v[84:87], v5, s[36:39], s53 offen sc1
    s_mov_b64 exec, -1
    s_cmp_lg_u32 s59, 3
    s_cbranch_scc1 L_nogate
    v_add_u32 v13, 151552, v10
    ds_read_b128 v[36:39], v13 offset:0
    ds_read_b128 v[40:43], v13 offset:1024
    ds_read_b128 v[44:47], v13 offset:2048
    ds_read_b128 v[48:51], v13 offset:3072
    v_mov_b32 v52, 0
    v_mov_b32 v53, 0
    v_mov_b32 v54, 0
    v_mov_b32 v55, 0
    s_waitcnt lgkmcnt(0)
    v_dot2c_f32_bf16 v52, v36, v88
    v_dot2c_f32_bf16 v53, v40, v88
    v_dot2c_f32_bf16 v54, v44, v88
    v_dot2c_f32_bf16 v55, v48, v88
    v_dot2c_f32_bf16 v52, v37, v89
    v_dot2c_f32_bf16 v53, v41, v89
    v_dot2c_f32_bf16 v54, v45, v89
    v_dot2c_f32_bf16 v55, v49, v89
    v_dot2c_f32_bf16 v52, v38, v90
    v_dot2c_f32_bf16 v53, v42, v90
    v_dot2c_f32_bf16 v54, v46, v90
    v_dot2c_f32_bf16 v55, v50, v90
    v_dot2c_f32_bf16 v52, v39, v91
    v_dot2c_f32_bf16 v53, v43, v91
    v_dot2c_f32_bf16 v54, v47, v91
    v_dot2c_f32_bf16 v55, v51, v91
    s_nop 1
    v_permlane32_swap_b32 v52, v54
    v_permlane32_swap_b32 v53, v55
    v_add_f32 v52, v52, v54
    v_add_f32 v53, v53, v55
    s_nop 1
    v_permlane16_swap_b32 v52, v53
    v_add_f32 v52, v52, v53
    s_nop 1
    v_add_f32_dpp v52, v52, v52 row_ror:8 row_mask:0xf bank_mask:0xf
    s_nop 1
    v_add_f32_dpp v52, v52, v52 row_ror:4 row_mask:0xf bank_mask:0xf
    s_nop 1
    v_add_f32_dpp v52, v52, v52 row_ror:2 row_mask:0xf bank_mask:0xf
    s_nop 1
    v_add_f32_dpp v52, v52, v52 row_ror:1 row_mask:0xf bank_mask:0xf
    s_mov_b32 s72, 0xbfb8aa3b
    v_mul_f32 v52, s72, v52
    v_exp_f32 v52, v52
    s_nop 0
    v_add_f32 v52, 1.0, v52
    v_rcp_f32 v52, v52
    v_lshlrev_b32 v12, 2, v3
    v_add_u32 v12, 135136, v12
    ds_write_b32 v12, v52
L_nogate:
    s_lshl_b32 s72, s62, 5
    s_lshl_b32 s73, s64, 4
    s_add_u32 s72, s72, s73
    s_lshl_b32 s72, s72, 11
    s_lshl_b32 s73, s59, 9
    s_add_u32 s72, s72, s73
    s_add_u32 s75, s72, 131072
    v_lshrrev_b32 v12, 2, v1
    v_lshlrev_b32 v12, 11, v12
    v_and_b32 v13, 3, v1
    v_lshl_add_u32 v12, v13, 4, v12
    s_lshl_b32 s72, s59, 12
    s_add_u32 s72, s72, 135168
    v_bfe_u32 v13, v1, 1, 1
    v_lshlrev_b32 v13, 8, v13
    v_lshrrev_b32 v14, 2, v1
    v_lshl_add_u32 v13, v14, 4, v13
    v_and_b32 v14, 1, v1
    v_lshl_add_u32 v13, v14, 3, v13
    v_add_u32 v13, s72, v13
    s_mov_b32 s3, 0
L_qlfull:
    buffer_load_dwordx4 v[20:23], v12, s[36:39], s75 offen offset:0 sc1
    buffer_load_dwordx4 v[24:27], v12, s[36:39], s75 offen offset:64 sc1
    buffer_load_dwordx4 v[28:31], v12, s[36:39], s75 offen offset:128 sc1
    buffer_load_dwordx4 v[32:35], v12, s[36:39], s75 offen offset:192 sc1
    buffer_load_dwordx4 v[36:39], v12, s[36:39], s75 offen offset:256 sc1
    buffer_load_dwordx4 v[40:43], v12, s[36:39], s75 offen offset:320 sc1
    buffer_load_dwordx4 v[44:47], v12, s[36:39], s75 offen offset:384 sc1
    buffer_load_dwordx4 v[48:51], v12, s[36:39], s75 offen offset:448 sc1
    s_waitcnt vmcnt(0)
    v_xor_b32 v248, s65, v22
    v_xor_b32 v249, s65, v26
    v_or_b32 v248, v248, v249
    v_xor_b32 v249, s65, v30
    v_or_b32 v248, v248, v249
    v_xor_b32 v249, s65, v34
    v_or_b32 v248, v248, v249
    v_xor_b32 v249, s65, v38
    v_or_b32 v248, v248, v249
    v_xor_b32 v249, s65, v42
    v_or_b32 v248, v248, v249
    v_xor_b32 v249, s65, v46
    v_or_b32 v248, v248, v249
    v_xor_b32 v249, s65, v50
    v_or_b32 v248, v248, v249
    v_cmp_ne_u32 vcc, 0, v248
    s_cbranch_vccz L_qlok
    s_add_u32 s3, s3, 1
    s_cmp_gt_u32 s3, 20000
    s_cbranch_scc1 L_qlok
    s_sleep 1
    s_branch L_qlfull
L_qlok:
    ds_write_b64 v13, v[20:21] offset:0
    ds_write_b64 v13, v[24:25] offset:512
    ds_write_b64 v13, v[28:29] offset:1024
    ds_write_b64 v13, v[32:33] offset:1536
    ds_write_b64 v13, v[36:37] offset:2048
    ds_write_b64 v13, v[40:41] offset:2560
    ds_write_b64 v13, v[44:45] offset:3072
    ds_write_b64 v13, v[48:49] offset:3584
L_join:
    s_mov_b32 s50, 4096
    s_mov_b32 s51, 0x20000
    s_mov_b32 s26, 4194304
    s_mov_b32 s27, 0x20000
    s_mov_b32 s34, 1409024
    s_mov_b32 s35, 0x20000
    s_mov_b32 s22, 4194304
    s_mov_b32 s23, 0x20000
    s_mov_b32 s46, 2752
    s_mov_b32 s47, 0x20000
    v_lshrrev_b32 v4, 4, v0
    v_lshlrev_b32 v4, 13, v4
    v_lshl_add_u32 v4, v2, 4, v4
    s_lshl_b32 s56, s61, 19
    s_lshl_b32 s73, s60, 8
    s_add_u32 s56, s56, s73
    v_lshrrev_b32 v5, 3, v0
    v_lshlrev_b32 v5, 10, v5
    v_and_b32 v6, 7, v0
    v_lshl_add_u32 v5, v6, 4, v5
    s_lshl_b32 s57, s60, 17
    s_lshl_b32 s73, s61, 7
    s_add_u32 s57, s57, s73
    s_lshl_b32 s58, s54, 16
    s_add_u32 s58, s58, s73
    s_lshl_b32 s72, s54, 7
    v_lshl_add_u32 v9, v1, 1, s72
    s_lshl_b32 s53, s64, 9
    s_add_u32 s53, s53, 425984
    v_lshlrev_b32 v11, 3, v1
    v_mov_b32 v140, -1
    v_mov_b32 v141, -1
    v_mov_b32 v142, -1
    v_mov_b32 v143, -1
    s_lshl_b32 s72, s60, 3
    s_add_u32 s72, s72, s61
    s_lshl_b32 s72, s72, 11
    s_lshl_b32 s73, s59, 8
    s_add_u32 s72, s72, s73
    s_add_u32 s72, s72, 524288
    v_lshlrev_b32 v18, 6, v3
    v_lshl_add_u32 v18, v2, 4, v18
    v_add_u32 v18, s72, v18
    s_lshl_b32 s72, s61, 15
    s_and_b32 s73, s59, 3
    s_lshl_b32 s73, s73, 13
    s_add_u32 s72, s72, s73
    s_lshl_b32 s73, s60, 6
    s_add_u32 s72, s72, s73
    s_add_u32 s72, s72, 1048576
    v_lshlrev_b32 v19, 11, v3
    v_lshl_add_u32 v19, v2, 4, v19
    v_add_u32 v19, s72, v19
    s_mul_i32 s72, s59, 16896
    v_mul_u32_u24 v14, 1056, v2
    v_lshl_add_u32 v14, v3, 4, v14
    v_add_u32 v14, s72, v14
    v_add_u32 v12, 135168, v10
    s_waitcnt vmcnt(0)
    s_waitcnt lgkmcnt(0)
    s_barrier
    ds_read_b128 v[148:151], v14 offset:0
    ds_read_b128 v[84:87], v12 offset:0
    ds_read_b128 v[152:155], v14 offset:64
    ds_read_b128 v[88:91], v12 offset:1024
    ds_read_b128 v[156:159], v14 offset:128
    ds_read_b128 v[92:95], v12 offset:2048
    ds_read_b128 v[160:163], v14 offset:192
    ds_read_b128 v[96:99], v12 offset:3072
    ds_read_b128 v[164:167], v14 offset:256
    ds_read_b128 v[100:103], v12 offset:4096
    ds_read_b128 v[168:171], v14 offset:320
    ds_read_b128 v[104:107], v12 offset:5120
    ds_read_b128 v[172:175], v14 offset:384
    ds_read_b128 v[108:111], v12 offset:6144
    s_waitcnt lgkmcnt(12)
    v_mfma_f32_16x16x32_bf16 v[228:231], v[148:151], v[84:87], 0
    ds_read_b128 v[176:179], v14 offset:448
    ds_read_b128 v[112:115], v12 offset:7168
    buffer_load_dwordx2 v[136:137], v11, s[36:39], s53 offen sc1
    s_waitcnt lgkmcnt(12)
    v_mfma_f32_16x16x32_bf16 v[228:231], v[152:155], v[88:91], v[228:231]
    ds_read_b128 v[180:183], v14 offset:512
    ds_read_b128 v[84:87], v12 offset:8192
    s_waitcnt lgkmcnt(12)
    v_mfma_f32_16x16x32_bf16 v[228:231], v[156:159], v[92:95], v[228:231]
    ds_read_b128 v[184:187], v14 offset:576
    ds_read_b128 v[88:91], v12 offset:9216
    buffer_load_dwordx4 v[116:119], v4, s[20:23], s56 offen nt
    s_add_u32 s56, s56, 262144
    s_waitcnt lgkmcnt(12)
    v_mfma_f32_16x16x32_bf16 v[228:231], v[160:163], v[96:99], v[228:231]
    ds_read_b128 v[188:191], v14 offset:640
    ds_read_b128 v[92:95], v12 offset:10240
    s_waitcnt lgkmcnt(12)
    v_mfma_f32_16x16x32_bf16 v[228:231], v[164:167], v[100:103], v[228:231]
    ds_read_b128 v[192:195], v14 offset:704
    ds_read_b128 v[96:99], v12 offset:11264
    buffer_load_dwordx4 v[124:127], v5, s[24:27], s57 offen nt
    s_add_u32 s57, s57, 65536
    s_waitcnt lgkmcnt(12)
    v_mfma_f32_16x16x32_bf16 v[228:231], v[168:171], v[104:107], v[228:231]
    ds_read_b128 v[196:199], v14 offset:768
    ds_read_b128 v[100:103], v12 offset:12288
    s_waitcnt lgkmcnt(12)
    v_mfma_f32_16x16x32_bf16 v[228:231], v[172:175], v[108:111], v[228:231]
    ds_read_b128 v[200:203], v14 offset:832
    ds_read_b128 v[104:107], v12 offset:13312
    buffer_load_dwordx4 v[120:123], v4, s[20:23], s56 offen nt
    s_waitcnt lgkmcnt(12)
    v_mfma_f32_16x16x32_bf16 v[228:231], v[176:179], v[112:115], v[228:231]
    ds_read_b128 v[204:207], v14 offset:896
    ds_read_b128 v[108:111], v12 offset:14336
    s_waitcnt lgkmcnt(12)
    v_mfma_f32_16x16x32_bf16 v[228:231], v[180:183], v[84:87], v[228:231]
    ds_read_b128 v[208:211], v14 offset:960
    ds_read_b128 v[112:115], v12 offset:15360
    buffer_load_dwordx4 v[128:131], v5, s[24:27], s57 offen nt
    s_waitcnt lgkmcnt(12)
    v_mfma_f32_16x16x32_bf16 v[228:231], v[184:187], v[88:91], v[228:231]
    s_waitcnt lgkmcnt(10)
    v_mfma_f32_16x16x32_bf16 v[228:231], v[188:191], v[92:95], v[228:231]
    buffer_load_dwordx4 v[132:135], v5, s[32:35], s58 offen nt
    s_waitcnt lgkmcnt(8)
    v_mfma_f32_16x16x32_bf16 v[228:231], v[192:195], v[96:99], v[228:231]
    s_waitcnt lgkmcnt(6)
    v_mfma_f32_16x16x32_bf16 v[228:231], v[196:199], v[100:103], v[228:231]
    buffer_load_ushort v9, v9, s[44:47], 0 offen
    s_waitcnt lgkmcnt(4)
    v_mfma_f32_16x16x32_bf16 v[228:231], v[200:203], v[104:107], v[228:231]
    s_waitcnt lgkmcnt(2)
    v_mfma_f32_16x16x32_bf16 v[228:231], v[204:207], v[108:111], v[228:231]
    s_waitcnt lgkmcnt(0)
    v_mfma_f32_16x16x32_bf16 v[228:231], v[208:211], v[112:115], v[228:231]
    s_mov_b32 exec_lo, 0x000f000f
    s_mov_b32 exec_hi, 0x000f000f
    s_mov_b32 s71, 5767168
    s_mov_b64 exec, -1
    v_bfe_u32 v13, v1, 2, 2
    v_lshl_add_u32 v13, v3, 2, v13
    v_mul_u32_u24 v13, 1056, v13
    v_and_b32 v14, 3, v1
    v_lshl_add_u32 v13, v14, 3, v13
    s_lshl_b32 s72, s59, 7
    v_add_u32 v13, s72, v13
    v_add_u32 v14, 67584, v13
    v_max3_f32 v248, v228, v229, v230
    v_max_f32 v248, v248, v231
    v_mov_b32 v249, v248
    s_nop 1
    v_permlane16_swap_b32 v248, v249
    v_max_f32 v248, v248, v249
    v_mov_b32 v249, v248
    s_nop 1
    v_permlane32_swap_b32 v248, v249
    v_max_f32 v248, v248, v249
    s_lshl_b32 s72, s59, 2
    s_add_u32 s72, s72, 161024
    v_mul_u32_u24 v12, 48, v2
    v_add_u32 v12, s72, v12
    ds_write_b32 v12, v248
    ds_read_b64_tr_b16 v[148:149], v13 offset:0
    ds_read_b64_tr_b16 v[150:151], v13 offset:16896
    ds_read_b64_tr_b16 v[152:153], v13 offset:32
    ds_read_b64_tr_b16 v[154:155], v13 offset:16928
    ds_read_b64_tr_b16 v[156:157], v13 offset:64
    ds_read_b64_tr_b16 v[158:159], v13 offset:16960
    ds_read_b64_tr_b16 v[160:161], v13 offset:96
    ds_read_b64_tr_b16 v[162:163], v13 offset:16992
    s_waitcnt lgkmcnt(0)
    s_barrier
    v_mul_u32_u24 v12, 48, v2
    v_add_u32 v12, 161024, v12
    ds_read_b128 v[212:215], v12
    ds_read_b128 v[216:219], v12 offset:16
    ds_read_b64_tr_b16 v[164:165], v13 offset:33792
    ds_read_b64_tr_b16 v[166:167], v13 offset:50688
    ds_read_b64_tr_b16 v[168:169], v13 offset:33824
    ds_read_b64_tr_b16 v[170:171], v13 offset:50720
    ds_read_b64_tr_b16 v[172:173], v13 offset:33856
    ds_read_b64_tr_b16 v[174:175], v13 offset:50752
    ds_read_b64_tr_b16 v[176:177], v13 offset:33888
    ds_read_b64_tr_b16 v[178:179], v13 offset:50784
    s_lshr_b32 s72, s59, 1
    s_lshl_b32 s72, s72, 10
    s_and_b32 s73, s59, 1
    s_lshl_b32 s73, s73, 3
    s_add_u32 s72, s72, s73
    s_add_u32 s72, s72, 155648
    v_add_u32 v12, s72, v10
    s_waitcnt lgkmcnt(8)
    v_max3_f32 v248, v212, v213, v214
    v_max3_f32 v249, v215, v216, v217
    v_max3_f32 v248, v248, v218, v219
    v_max_f32 v252, v248, v249
    v_sub_f32 v228, v228, v252
    v_sub_f32 v229, v229, v252
    v_sub_f32 v230, v230, v252
    v_sub_f32 v231, v231, v252
    v_exp_f32 v228, v228
    v_exp_f32 v229, v229
    v_exp_f32 v230, v230
    v_exp_f32 v231, v231
    v_cvt_pk_bf16_f32 v248, v228, v229
    v_cvt_pk_bf16_f32 v249, v230, v231
    ds_write_b64 v12, v[248:249]
    s_waitcnt lgkmcnt(0)
    s_barrier
    v_add_u32 v12, 155648, v10
    ds_read_b128 v[212:215], v12 offset:0
    ds_read_b128 v[216:219], v12 offset:1024
    ds_read_b128 v[220:223], v12 offset:2048
    ds_read_b128 v[224:227], v12 offset:3072
    ds_read_b64_tr_b16 v[180:181], v14 offset:0
    ds_read_b64_tr_b16 v[182:183], v14 offset:16896
    ds_read_b64_tr_b16 v[184:185], v14 offset:32
    ds_read_b64_tr_b16 v[186:187], v14 offset:16928
    ds_read_b64_tr_b16 v[188:189], v14 offset:64
    ds_read_b64_tr_b16 v[190:191], v14 offset:16960
    ds_read_b64_tr_b16 v[192:193], v14 offset:96
    ds_read_b64_tr_b16 v[194:195], v14 offset:16992
    v_mov_b32 v84, 0x3f803f80
    v_mov_b32 v85, 0x3f803f80
    v_mov_b32 v86, 0x3f803f80
    v_mov_b32 v87, 0x3f803f80
    s_waitcnt lgkmcnt(11)
    v_mfma_f32_16x16x32_bf16 v[228:231], v[148:151], v[212:215], 0
    v_mfma_f32_16x16x32_bf16 v[232:235], v[152:155], v[212:215], 0
    v_mfma_f32_16x16x32_bf16 v[236:239], v[156:159], v[212:215], 0
    v_mfma_f32_16x16x32_bf16 v[240:243], v[160:163], v[212:215], 0
    ds_read_b64_tr_b16 v[196:197], v14 offset:33792
    ds_read_b64_tr_b16 v[198:199], v14 offset:50688
    ds_read_b64_tr_b16 v[200:201], v14 offset:33824
    ds_read_b64_tr_b16 v[202:203], v14 offset:50720
    ds_read_b64_tr_b16 v[204:205], v14 offset:33856
    ds_read_b64_tr_b16 v[206:207], v14 offset:50752
    ds_read_b64_tr_b16 v[208:209], v14 offset:33888
    ds_read_b64_tr_b16 v[210:211], v14 offset:50784
    s_waitcnt lgkmcnt(15)
    s_waitcnt lgkmcnt(14)
    v_mfma_f32_16x16x32_bf16 v[228:231], v[164:167], v[216:219], v[228:231]
    v_mfma_f32_16x16x32_bf16 v[232:235], v[168:171], v[216:219], v[232:235]
    v_mfma_f32_16x16x32_bf16 v[236:239], v[172:175], v[216:219], v[236:239]
    v_mfma_f32_16x16x32_bf16 v[240:243], v[176:179], v[216:219], v[240:243]
    s_waitcnt lgkmcnt(8)
    v_mfma_f32_16x16x32_bf16 v[228:231], v[180:183], v[220:223], v[228:231]
    v_mfma_f32_16x16x32_bf16 v[232:235], v[184:187], v[220:223], v[232:235]
    v_mfma_f32_16x16x32_bf16 v[236:239], v[188:191], v[220:223], v[236:239]
    v_mfma_f32_16x16x32_bf16 v[240:243], v[192:195], v[220:223], v[240:243]
    s_waitcnt lgkmcnt(0)
    v_mfma_f32_16x16x32_bf16 v[228:231], v[196:199], v[224:227], v[228:231]
    v_mfma_f32_16x16x32_bf16 v[232:235], v[200:203], v[224:227], v[232:235]
    v_mfma_f32_16x16x32_bf16 v[236:239], v[204:207], v[224:227], v[236:239]
    v_mfma_f32_16x16x32_bf16 v[240:243], v[208:211], v[224:227], v[240:243]
    s_cmp_lg_u32 s59, 0
    s_cbranch_scc1 L_nol
    v_mfma_f32_16x16x32_bf16 v[244:247], v[84:87], v[212:215], 0
    v_mfma_f32_16x16x32_bf16 v[244:247], v[84:87], v[216:219], v[244:247]
    v_mfma_f32_16x16x32_bf16 v[244:247], v[84:87], v[220:223], v[244:247]
    v_mfma_f32_16x16x32_bf16 v[244:247], v[84:87], v[224:227], v[244:247]
L_nol:
    s_lshl_b32 s72, s64, 21
    s_lshl_b32 s73, s59, 14
    s_add_u32 s72, s72, s73
    s_lshl_b32 s73, s62, 5
    s_add_u32 s73, s73, s63
    s_lshl_b32 s75, s73, 7
    s_add_u32 s72, s72, s75
    s_add_u32 s72, s72, 2097152
    v_lshrrev_b32 v12, 3, v1
    v_lshlrev_b32 v12, 17, v12
    v_and_b32 v13, 7, v1
    v_lshl_add_u32 v12, v13, 4, v12
    s_add_u32 s74, s72, 1048576
    s_lshl_b32 s71, s59, 11
    s_add_u32 s71, s71, 135168
    v_lshrrev_b32 v14, 1, v3
    v_and_b32 v15, 7, v2
    v_xor_b32 v14, v14, v15
    v_lshlrev_b32 v14, 4, v14
    v_lshlrev_b32 v15, 7, v2
    v_and_b32 v16, 1, v3
    v_lshl_add_u32 v15, v16, 3, v15
    v_add_u32 v15, s71, v15
    v_lshrrev_b32 v16, 3, v1
    v_and_b32 v17, 7, v1
    v_xor_b32 v17, v17, v16
    v_lshlrev_b32 v17, 4, v17
    v_lshl_add_u32 v17, v16, 7, v17
    v_add_u32 v17, s71, v17
    s_lshl_b32 s73, s73, 3
    s_lshl_b32 s75, s64, 14
    s_add_u32 s73, s73, s75
    s_add_u32 s73, s73, 393216
    v_lshlrev_b32 v13, 10, v2
    v_cvt_pk_bf16_f32 v92, v228, v229
    v_cvt_pk_bf16_f32 v93, v230, v231
    v_xor_b32 v16, 0, v14
    v_add_u32 v16, v16, v15
    ds_write_b64 v16, v[92:93]
    v_cvt_pk_bf16_f32 v94, v232, v233
    v_cvt_pk_bf16_f32 v95, v234, v235
    v_xor_b32 v16, 32, v14
    v_add_u32 v16, v16, v15
    ds_write_b64 v16, v[94:95]
    v_cvt_pk_bf16_f32 v96, v236, v237
    v_cvt_pk_bf16_f32 v97, v238, v239
    v_xor_b32 v16, 64, v14
    v_add_u32 v16, v16, v15
    ds_write_b64 v16, v[96:97]
    v_cvt_pk_bf16_f32 v98, v240, v241
    v_cvt_pk_bf16_f32 v99, v242, v243
    v_xor_b32 v16, 96, v14
    v_add_u32 v16, v16, v15
    ds_write_b64 v16, v[98:99]
    s_waitcnt lgkmcnt(0)
    ds_read_b128 v[92:95], v17 offset:0
    ds_read_b128 v[96:99], v17 offset:1024
    s_waitcnt vmcnt(6)
    s_mov_b32 s3, 0
L_cfcheck:
    v_cmp_ne_u32 s[76:77], s65, v136
    v_cmp_ne_u32 s[78:79], s65, v137
    s_or_b64 vcc, s[76:77], s[78:79]
    s_cbranch_scc0 L_cfok
    s_add_u32 s3, s3, 1
    s_cmp_gt_u32 s3, 20000
    s_cbranch_scc1 L_cfok
    s_sleep 1
    buffer_load_dwordx2 v[136:137], v11, s[36:39], s53 offen sc1
    s_waitcnt vmcnt(0)
    s_branch L_cfcheck
L_cfok:
    s_waitcnt lgkmcnt(1)
    buffer_store_dwordx4 v[92:95], v12, s[36:39], s72 offen sc1
    s_waitcnt lgkmcnt(0)
    buffer_store_dwordx4 v[96:99], v12, s[36:39], s74 offen sc1
    s_cmp_lg_u32 s59, 0
    s_cbranch_scc1 L_nostat
    v_mov_b32 v248, v252
    v_mov_b32 v249, v244
    s_mov_b64 exec, 0xffff
    buffer_store_dwordx2 v[248:249], v13, s[36:39], s73 offen sc1
    s_mov_b64 exec, -1
L_nostat:
    s_waitcnt lgkmcnt(0)
    s_barrier
    s_mov_b32 s20, 0x7060500
    s_mov_b32 s21, 0x7060501
    s_mov_b32 s22, 0x7060502
    s_mov_b32 s23, 0x7060503
    s_mov_b32 s44, 0x0c0c0400
    s_mov_b32 s45, 0x04000c0c
    s_mov_b32 s46, 0xffffff00
    s_lshl_b32 s72, s60, 3
    s_add_u32 s72, s72, s59
    s_lshl_b32 s72, s72, 10
    s_add_u32 s47, s72, 1310720
    s_cmp_eq_u32 s55, 0
    s_cbranch_scc1 L_hxskip
    buffer_load_dwordx4 v[212:215], v10, s[36:39], s47 offen sc1
L_hxskip:
    s_mov_b32 s71, 5767168
    s_mov_b32 exec_lo, 0x000f000f
    s_mov_b32 exec_hi, 0x000f000f
    buffer_load_dwordx4 v[144:147], v18, s[36:39], s71 offen sc1
    s_mov_b64 exec, -1
    v_lshrrev_b32 v12, 4, v0
    v_and_b32 v13, 3, v12
    v_bfe_u32 v14, v12, 3, 1
    v_lshl_add_u32 v13, v14, 2, v13
    v_lshlrev_b32 v13, 1, v13
    v_xor_b32 v13, v13, v2
    v_lshlrev_b32 v13, 4, v13
    v_lshl_add_u32 v148, v12, 8, v13
    v_lshrrev_b32 v12, 3, v0
    v_bfe_u32 v13, v12, 1, 1
    v_bfe_u32 v14, v12, 3, 1
    v_lshl_add_u32 v13, v14, 1, v13
    v_lshlrev_b32 v13, 1, v13
    v_and_b32 v14, 7, v0
    v_xor_b32 v13, v13, v14
    v_lshlrev_b32 v13, 4, v13
    v_lshl_add_u32 v149, v12, 7, v13
    v_and_b32 v12, 7, v1
    v_lshlrev_b32 v12, 3, v12
    v_bfe_u32 v13, v1, 3, 1
    v_add_u32 v12, v12, v13
    v_lshl_add_u32 v12, v3, 1, v12
    s_mul_i32 s72, s59, 160
    s_add_u32 s72, s72, 159744
    v_lshl_add_u32 v150, v12, 1, s72
    v_lshrrev_b32 v12, 2, v2
    v_and_b32 v13, 1, v3
    v_lshl_add_u32 v13, v13, 2, v12
    v_lshlrev_b32 v13, 1, v13
    v_bfe_u32 v14, v2, 1, 1
    s_lshl_b32 s72, s59, 1
    v_add_u32 v14, s72, v14
    v_xor_b32 v13, v13, v14
    v_lshlrev_b32 v13, 4, v13
    v_and_b32 v14, 1, v2
    v_lshl_add_u32 v13, v14, 3, v13
    v_lshl_add_u32 v12, v3, 3, v12
    v_lshl_add_u32 v151, v12, 8, v13
    v_and_b32 v12, 3, v2
    v_bfe_u32 v13, v2, 2, 1
    v_lshl_add_u32 v13, v12, 1, v13
    v_mul_u32_u24 v13, 160, v13
    v_lshl_add_u32 v13, v3, 4, v13
    v_add_u32 v152, 159744, v13
    v_lshlrev_b32 v13, 2, v12
    v_add_u32 v153, 135136, v13
    v_bfe_u32 v13, v2, 3, 1
    v_and_b32 v14, 1, v3
    v_lshl_add_u32 v13, v14, 1, v13
    v_lshlrev_b32 v13, 1, v13
    s_and_b32 s72, s59, 3
    s_lshl_b32 s72, s72, 1
    v_bfe_u32 v14, v2, 1, 1
    v_add_u32 v14, s72, v14
    v_xor_b32 v13, v13, v14
    v_lshlrev_b32 v13, 4, v13
    v_and_b32 v14, 1, v2
    v_lshl_add_u32 v13, v14, 3, v13
    v_lshrrev_b32 v14, 2, v2
    v_lshl_add_u32 v14, v3, 3, v14
    v_lshl_add_u32 v154, v14, 7, v13
    v_lshrrev_b32 v13, 7, v0
    v_and_b32 v14, 3, v0
    v_lshl_add_u32 v13, v13, 2, v14
    v_mul_u32_u24 v13, 288, v13
    v_bfe_u32 v14, v0, 2, 5
    v_lshl_add_u32 v155, v14, 3, v13
    v_mul_u32_u24 v13, 288, v2
    v_lshl_add_u32 v156, v3, 4, v13
    v_mul_u32_u24 v13, 160, v12
    v_lshl_add_u32 v13, v3, 4, v13
    v_add_u32 v13, 161792, v13
    v_lshlrev_b32 v14, 4, v3
    v_add_u32 v14, 162432, v14
    v_cmp_gt_u32 vcc, 4, v2
    s_nop 1
    v_cndmask_b32 v157, v14, v13, vcc
    s_lshl_b32 s72, s59, 4
    s_add_u32 s72, s72, 46080
    v_lshrrev_b32 v13, 2, v1
    v_lshlrev_b32 v13, 6, v13
    v_and_b32 v14, 3, v1
    v_lshl_add_u32 v13, v14, 2, v13
    v_add_u32 v158, s72, v13
    s_mul_i32 s72, s59, 160
    s_add_u32 s72, s72, 161792
    v_lshl_add_u32 v159, v1, 1, s72
    s_cmp_lg_u32 s59, 7
    s_cbranch_scc1 L_nozero
    v_mov_b32 v248, 0
    v_lshlrev_b32 v12, 2, v1
    v_add_u32 v12, 162432, v12
    s_mov_b64 exec, 0xffffffff
    ds_write_b32 v12, v248
    s_mov_b64 exec, -1
L_nozero:
    s_lshl_b32 s72, s59, 11
    s_add_u32 s72, s72, s52
    s_lshr_b32 s73, s59, 1
    s_lshl_b32 s73, s73, 8
    s_lshl_b32 s75, s60, 10
    s_add_u32 s73, s73, s75
    s_add_u32 s73, s73, 393216
    s_and_b32 s75, s59, 1
    s_lshl_b32 s75, s75, 7
    v_lshrrev_b32 v15, 3, v1
    v_lshlrev_b32 v15, 3, v15
    v_xor_b32 v16, 128, v15
    v_xor_b32 v15, s75, v15
    v_xor_b32 v16, s75, v16
    s_waitcnt vmcnt(0)
    buffer_load_dwordx2 v[220:221], v15, s[36:39], s73 offen offset:0 sc1
    buffer_load_dwordx2 v[222:223], v15, s[36:39], s73 offen offset:64 sc1
    buffer_load_dwordx2 v[224:225], v16, s[36:39], s73 offen offset:0 sc1
    buffer_load_dwordx2 v[226:227], v16, s[36:39], s73 offen offset:64 sc1
    ds_write_b128 v148, v[116:119] offset:0
    ds_write_b128 v148, v[120:123] offset:8192
    ds_write_b128 v149, v[124:127] offset:16384
    ds_write_b128 v149, v[128:131] offset:24576
    ds_write_b128 v149, v[132:135] offset:32768
    s_cmp_eq_u32 s55, 0
    s_cbranch_scc1 L_hxdone
    s_mov_b32 s3, 0
L_hxcheck:
    v_perm_b32 v248, v213, v212, s44
    v_perm_b32 v249, v215, v214, s45
    v_or_b32 v248, v248, v249
    v_cmp_ne_u32 vcc, s65, v248
    s_cbranch_vccz L_hxok
    s_add_u32 s3, s3, 1
    s_cmp_gt_u32 s3, 20000
    s_cbranch_scc1 L_hxok
    s_sleep 1
    buffer_load_dwordx4 v[212:215], v10, s[36:39], s47 offen sc1
    s_waitcnt vmcnt(0)
    s_branch L_hxcheck
L_hxok:
    v_and_b32 v212, s46, v212
    v_and_b32 v213, s46, v213
    v_and_b32 v214, s46, v214
    v_and_b32 v215, s46, v215
    s_lshl_b32 s75, s59, 10
    s_add_u32 s75, s75, 46080
    v_add_u32 v12, s75, v10
    ds_write_b128 v12, v[212:215]
L_hxdone:
    s_mov_b32 s3, 0
    s_waitcnt vmcnt(0)
    s_branch L_statchk
L_statpoll:
    buffer_load_dwordx2 v[220:221], v15, s[36:39], s73 offen offset:0 sc1
    buffer_load_dwordx2 v[222:223], v15, s[36:39], s73 offen offset:64 sc1
    buffer_load_dwordx2 v[224:225], v16, s[36:39], s73 offen offset:0 sc1
    buffer_load_dwordx2 v[226:227], v16, s[36:39], s73 offen offset:64 sc1
    s_waitcnt vmcnt(0)
L_statchk:
    v_max3_u32 v248, v220, v221, v222
    v_max3_u32 v249, v223, v224, v225
    v_max3_u32 v248, v248, v226, v227
    v_max_u32 v248, v248, v249
    v_cmp_eq_u32 vcc, -1, v248
    s_cbranch_vccz L_statok
    s_add_u32 s3, s3, 1
    s_cmp_gt_u32 s3, 20000
    s_cbranch_scc1 L_statok
    s_sleep 1
    s_branch L_statpoll
L_statok:
    buffer_load_dwordx4 v[212:215], v10, s[36:39], s72 offen offset:0 sc1
    buffer_load_dwordx4 v[216:219], v10, s[36:39], s72 offen offset:1024 sc1
    v_max3_f32 v248, v220, v222, v224
    v_max_f32 v248, v248, v226
    s_nop 1
    v_max_f32_dpp v248, v248, v248 row_ror:8 row_mask:0xf bank_mask:0xf
    v_mov_b32 v249, v248
    s_nop 1
    v_permlane16_swap_b32 v248, v249
    v_max_f32 v248, v248, v249
    v_mov_b32 v249, v248
    s_nop 1
    v_permlane32_swap_b32 v248, v249
    v_max_f32 v248, v248, v249
    v_sub_f32 v220, v220, v248
    v_sub_f32 v222, v222, v248
    v_sub_f32 v224, v224, v248
    v_sub_f32 v226, v226, v248
    v_exp_f32 v220, v220
    v_exp_f32 v222, v222
    v_exp_f32 v224, v224
    v_exp_f32 v226, v226
    v_mul_f32 v249, v220, v221
    v_fmac_f32 v249, v222, v223
    v_fmac_f32 v249, v224, v225
    v_fmac_f32 v249, v226, v227
    s_nop 1
    v_add_f32_dpp v249, v249, v249 row_ror:8 row_mask:0xf bank_mask:0xf
    v_mov_b32 v250, v249
    s_nop 1
    v_permlane16_swap_b32 v249, v250
    v_add_f32 v249, v249, v250
    v_mov_b32 v250, v249
    s_nop 1
    v_permlane32_swap_b32 v249, v250
    v_add_f32 v249, v249, v250
    v_rcp_f32 v249, v249
    v_and_b32 v251, 8, v1
    v_cmp_eq_u32 s[78:79], 0, v251
    v_mul_f32 v220, v220, v249
    v_mul_f32 v222, v222, v249
    s_mov_b32 s3, 0
    s_waitcnt vmcnt(0)
L_partcheck:
    v_max3_u32 v248, v212, v213, v214
    v_max3_u32 v249, v215, v216, v217
    v_max3_u32 v248, v248, v218, v219
    v_max_u32 v248, v248, v249
    v_cmp_eq_u32 vcc, -1, v248
    s_cbranch_vccz L_partok
    s_add_u32 s3, s3, 1
    s_cmp_gt_u32 s3, 20000
    s_cbranch_scc1 L_partok
    s_sleep 1
    buffer_load_dwordx4 v[212:215], v10, s[36:39], s72 offen offset:0 sc1
    buffer_load_dwordx4 v[216:219], v10, s[36:39], s72 offen offset:1024 sc1
    s_waitcnt vmcnt(0)
    s_branch L_partcheck
L_partok:
    v_lshlrev_b32 v108, 16, v212
    v_and_b32 v109, 0xffff0000, v212
    v_lshlrev_b32 v110, 16, v213
    v_and_b32 v111, 0xffff0000, v213
    v_lshlrev_b32 v112, 16, v214
    v_and_b32 v113, 0xffff0000, v214
    v_lshlrev_b32 v114, 16, v215
    v_and_b32 v115, 0xffff0000, v215
    v_pk_mul_f32 v[100:101], v[108:109], v[220:221] op_sel_hi:[1,0]
    v_pk_mul_f32 v[102:103], v[110:111], v[220:221] op_sel_hi:[1,0]
    v_pk_mul_f32 v[104:105], v[112:113], v[220:221] op_sel_hi:[1,0]
    v_pk_mul_f32 v[106:107], v[114:115], v[220:221] op_sel_hi:[1,0]
    v_lshlrev_b32 v108, 16, v216
    v_and_b32 v109, 0xffff0000, v216
    v_lshlrev_b32 v110, 16, v217
    v_and_b32 v111, 0xffff0000, v217
    v_lshlrev_b32 v112, 16, v218
    v_and_b32 v113, 0xffff0000, v218
    v_lshlrev_b32 v114, 16, v219
    v_and_b32 v115, 0xffff0000, v219
    v_pk_fma_f32 v[100:101], v[108:109], v[222:223], v[100:101] op_sel_hi:[1,0,1]
    v_pk_fma_f32 v[102:103], v[110:111], v[222:223], v[102:103] op_sel_hi:[1,0,1]
    v_pk_fma_f32 v[104:105], v[112:113], v[222:223], v[104:105] op_sel_hi:[1,0,1]
    v_pk_fma_f32 v[106:107], v[114:115], v[222:223], v[106:107] op_sel_hi:[1,0,1]
    s_nop 0
    v_permlane32_swap_b32 v100, v104
    v_permlane32_swap_b32 v101, v105
    v_permlane32_swap_b32 v102, v106
    v_permlane32_swap_b32 v103, v107
    v_add_f32 v100, v100, v104
    v_add_f32 v101, v101, v105
    v_add_f32 v102, v102, v106
    v_add_f32 v103, v103, v107
    s_nop 0
    v_permlane16_swap_b32 v100, v102
    v_permlane16_swap_b32 v101, v103
    v_add_f32 v100, v100, v102
    v_add_f32 v101, v101, v103
    s_nop 0
    v_add_f32_dpp v100, v100, v100 row_ror:8 row_mask:0xf bank_mask:0xf
    v_add_f32_dpp v101, v101, v101 row_ror:8 row_mask:0xf bank_mask:0xf
    v_cndmask_b32 v100, v101, v100, s[78:79]
    v_cvt_pk_bf16_f32 v100, v100, v100
    ds_write_b16 v150, v100
    s_waitcnt lgkmcnt(0)
    s_barrier
    ds_read_b64_tr_b16 v[228:229], v151 offset:0
    ds_read_b64_tr_b16 v[230:231], v151 offset:1024
    ds_read_b64_tr_b16 v[232:233], v151 offset:8192
    ds_read_b64_tr_b16 v[234:235], v151 offset:9216
    ds_read_b128 v[212:215], v152 offset:0
    ds_read_b128 v[216:219], v152 offset:64
    ds_read_b32 v252, v153
    v_mov_b32 v253, s65
    s_lshl_b32 s72, s60, 14
    s_add_u32 s72, s72, 6291456
    s_add_u32 s73, s72, 8192
    v_lshlrev_b32 v12, 4, v0
    s_mov_b32 s57, 5767168
    s_waitcnt lgkmcnt(2)
    v_mfma_f32_16x16x32_bf16 v[236:239], v[228:231], v[212:215], 0
    s_waitcnt lgkmcnt(1)
    v_mfma_f32_16x16x32_bf16 v[236:239], v[232:235], v[216:219], v[236:239]
    s_mov_b32 s3, 0
    s_waitcnt lgkmcnt(0)
    s_nop 5
    v_add_f32_dpp v236, v236, v236 row_ror:4 row_mask:0xf bank_mask:0xf
    v_add_f32_dpp v237, v237, v237 row_ror:4 row_mask:0xf bank_mask:0xf
    v_add_f32_dpp v238, v238, v238 row_ror:4 row_mask:0xf bank_mask:0xf
    v_add_f32_dpp v239, v239, v239 row_ror:4 row_mask:0xf bank_mask:0xf
    v_mul_f32 v236, v252, v236
    v_mul_f32 v237, v252, v237
    v_mul_f32 v238, v252, v238
    v_mul_f32 v239, v252, v239
    v_perm_b32 v92, v236, v253, s20
    v_perm_b32 v93, v237, v253, s21
    v_perm_b32 v94, v238, v253, s22
    v_perm_b32 v95, v239, v253, s23
    s_mov_b32 exec_lo, 0x000f000f
    s_mov_b32 exec_hi, 0x000f000f
    buffer_store_dwordx4 v[92:95], v18, s[36:39], s57 offen
    s_mov_b64 exec, -1
    s_waitcnt vmcnt(0)
    buffer_load_dwordx4 v[212:215], v12, s[36:39], s72 offen sc1
    buffer_load_dwordx4 v[216:219], v12, s[36:39], s73 offen sc1
    s_cmp_ge_u32 s59, 4
    s_cbranch_scc1 L_noact
    ds_read_b64_tr_b16 v[20:21], v154 offset:16384
    ds_read_b64_tr_b16 v[22:23], v154 offset:16896
    ds_read_b64_tr_b16 v[24:25], v154 offset:20480
    ds_read_b64_tr_b16 v[26:27], v154 offset:20992
    ds_read_b64_tr_b16 v[28:29], v154 offset:24576
    ds_read_b64_tr_b16 v[30:31], v154 offset:25088
    ds_read_b64_tr_b16 v[32:33], v154 offset:28672
    ds_read_b64_tr_b16 v[34:35], v154 offset:29184
    ds_read_b64_tr_b16 v[36:37], v154 offset:32768
    ds_read_b64_tr_b16 v[38:39], v154 offset:33280
    ds_read_b64_tr_b16 v[40:41], v154 offset:36864
    ds_read_b64_tr_b16 v[42:43], v154 offset:37376
    v_mov_b32 v105, 0
    s_cmp_eq_u32 s55, 0
    s_cbranch_scc1 L_actw
    ds_read2st64_b32 v[108:109], v158 offset0:0 offset1:4
    ds_read2st64_b32 v[110:111], v158 offset0:8 offset1:12
    ds_read2st64_b32 v[112:113], v158 offset0:16 offset1:20
    ds_read2st64_b32 v[114:115], v158 offset0:24 offset1:28
    s_lshl_b32 s74, s59, 2
    s_add_u32 s74, s74, 135136
    v_mov_b32 v13, s74
    ds_read_b32 v101, v13
    v_lshlrev_b32 v9, 16, v9
    s_mov_b32 s74, 0xbfb8aa3b
    s_waitcnt lgkmcnt(0)
    v_add_f32 v108, v108, v109
    v_add_f32 v110, v110, v111
    v_add_f32 v112, v112, v113
    v_add_f32 v114, v114, v115
    v_add_f32 v108, v108, v110
    v_add_f32 v112, v112, v114
    v_add_f32 v108, v108, v112
    v_add_f32 v100, v108, v9
    v_mul_f32_e64 v103, s74, abs(v100)
    v_exp_f32 v103, v103
    s_nop 0
    v_add_f32 v104, v103, v103
    v_add_f32 v105, 1.0, v104
    v_fma_f32 v106, v103, v103, v104
    v_mul_f32 v107, v103, v104
    v_cmp_le_f32 vcc, 0, v100
    s_nop 1
    v_cndmask_b32 v105, v106, v105, vcc
    v_cndmask_b32 v107, 2.0, v107, vcc
    v_add_f32 v107, v105, v107
    v_rcp_f32 v107, v107
    v_mul_f32 v105, v105, v100
    v_mul_f32 v105, v105, v107
    v_sub_f32 v101, 1.0, v101
    v_mul_f32 v105, v105, v101
    s_lshl_b32 s74, s54, 6
    v_add_u32 v13, s74, v1
    v_cmp_gt_u32 vcc, 1376, v13
    s_nop 1
    v_cndmask_b32 v105, 0, v105, vcc
    v_cvt_pk_bf16_f32 v105, v105, v105
L_actw:
    ds_write_b16 v159, v105
L_noact:
L_pctxcheck:
    s_waitcnt vmcnt(0)
    v_perm_b32 v248, v213, v212, s44
    v_perm_b32 v249, v215, v214, s45
    v_or_b32 v248, v248, v249
    v_perm_b32 v250, v217, v216, s44
    v_perm_b32 v251, v219, v218, s45
    v_or_b32 v250, v250, v251
    v_cmp_ne_u32 s[76:77], s65, v248
    v_cmp_ne_u32 s[78:79], s65, v250
    s_or_b64 vcc, s[76:77], s[78:79]
    s_cbranch_scc0 L_pctxok
    s_add_u32 s3, s3, 1
    s_cmp_gt_u32 s3, 20000
    s_cbranch_scc1 L_pctxok
    s_cmp_lt_u32 s3, 6
    s_cbranch_scc1 L_pctxagain
    s_cmp_lg_u32 s3, 6
    s_cbranch_scc1 L_pctxflip
    s_mov_b32 exec_lo, 0x000f000f
    s_mov_b32 exec_hi, 0x000f000f
    buffer_store_dwordx4 v[92:95], v18, s[36:39], 0 offen sc1
    s_mov_b64 exec, -1
L_pctxflip:
    s_xor_b32 s72, s72, 6815744
    s_xor_b32 s73, s73, 6815744
    s_sleep 1
L_pctxagain:
    buffer_load_dwordx4 v[212:215], v12, s[36:39], s72 offen sc1
    buffer_load_dwordx4 v[216:219], v12, s[36:39], s73 offen sc1
    s_branch L_pctxcheck
L_pctxok:
    v_and_b32 v212, s46, v212
    v_and_b32 v213, s46, v213
    v_and_b32 v214, s46, v214
    v_and_b32 v215, s46, v215
    v_and_b32 v216, s46, v216
    v_and_b32 v217, s46, v217
    v_and_b32 v218, s46, v218
    v_and_b32 v219, s46, v219
    v_pk_add_f32 v[212:213], v[212:213], v[216:217]
    v_pk_add_f32 v[214:215], v[214:215], v[218:219]
    v_cvt_pk_bf16_f32 v212, v212, v213
    v_cvt_pk_bf16_f32 v213, v214, v215
    ds_write_b64 v155, v[212:213] offset:40960
    s_cmp_ge_u32 s3, 6
    s_cbranch_scc1 L_pctxsdone
    s_mov_b32 exec_lo, 0x000f000f
    s_mov_b32 exec_hi, 0x000f000f
    buffer_store_dwordx4 v[92:95], v18, s[36:39], 0 offen sc1
    s_mov_b64 exec, -1
L_pctxsdone:
    s_waitcnt lgkmcnt(0)
    s_barrier
    s_cmp_ge_u32 s59, 4
    s_cbranch_scc1 L_fin
    ds_read_b128 v[212:215], v156 offset:40960
    ds_read_b128 v[216:219], v156 offset:41024
    ds_read_b128 v[220:223], v156 offset:41088
    ds_read_b128 v[224:227], v156 offset:41152
    ds_read_b128 v[84:87], v157 offset:0
    ds_read_b128 v[88:91], v157 offset:64
    s_waitcnt lgkmcnt(5)
    v_mfma_f32_16x16x32_bf16 v[228:231], v[20:23], v[212:215], 0
    s_waitcnt lgkmcnt(4)
    v_mfma_f32_16x16x32_bf16 v[228:231], v[24:27], v[216:219], v[228:231]
    s_waitcnt lgkmcnt(3)
    v_mfma_f32_16x16x32_bf16 v[228:231], v[28:31], v[220:223], v[228:231]
    s_waitcnt lgkmcnt(2)
    v_mfma_f32_16x16x32_bf16 v[228:231], v[32:35], v[224:227], v[228:231]
    s_waitcnt lgkmcnt(1)
    v_mfma_f32_16x16x32_bf16 v[228:231], v[36:39], v[84:87], v[228:231]
    s_waitcnt lgkmcnt(0)
    v_mfma_f32_16x16x32_bf16 v[228:231], v[40:43], v[88:91], v[228:231]
    s_nop 7
    v_add_f32_dpp v228, v228, v228 row_ror:4 row_mask:0xf bank_mask:0xf
    v_add_f32_dpp v229, v229, v229 row_ror:4 row_mask:0xf bank_mask:0xf
    v_add_f32_dpp v230, v230, v230 row_ror:4 row_mask:0xf bank_mask:0xf
    v_add_f32_dpp v231, v231, v231 row_ror:4 row_mask:0xf bank_mask:0xf
    v_add_f32_dpp v228, v228, v228 row_ror:8 row_mask:0xf bank_mask:0xf
    v_add_f32_dpp v229, v229, v229 row_ror:8 row_mask:0xf bank_mask:0xf
    v_add_f32_dpp v230, v230, v230 row_ror:8 row_mask:0xf bank_mask:0xf
    v_add_f32_dpp v231, v231, v231 row_ror:8 row_mask:0xf bank_mask:0xf
    v_perm_b32 v248, v228, v253, s20
    v_perm_b32 v249, v229, v253, s21
    v_perm_b32 v250, v230, v253, s22
    v_perm_b32 v251, v231, v253, s23
    s_mov_b32 exec_lo, 0x000f000f
    s_mov_b32 exec_hi, 0x000f000f
    buffer_store_dwordx4 v[248:251], v19, s[36:39], 0 offen sc1
    s_mov_b64 exec, -1
    s_cmp_ge_u32 s2, 128
    s_cbranch_scc1 L_fin
    s_cmp_lg_u32 s59, 0
    s_cbranch_scc1 L_fin
    s_lshl_b32 s72, s2, 11
    s_add_u32 s72, s72, 1048576
    s_lshl_b32 s70, s2, 2
    v_and_b32 v13, 3, v1
    v_lshlrev_b32 v13, 9, v13
    v_add3_u32 v13, v13, v3, s70
    v_lshlrev_b32 v13, 1, v13
    s_mov_b32 s3, 0
    s_waitcnt vmcnt(0)
L_poutpoll:
    buffer_load_dwordx4 v[212:215], v10, s[36:39], s72 offen sc1
    buffer_load_dwordx4 v[216:219], v10, s[36:39], s72 offen offset:1024 sc1
    s_waitcnt vmcnt(0)
    v_perm_b32 v248, v213, v212, s44
    v_perm_b32 v249, v215, v214, s45
    v_or_b32 v248, v248, v249
    v_perm_b32 v250, v217, v216, s44
    v_perm_b32 v251, v219, v218, s45
    v_or_b32 v250, v250, v251
    v_cmp_ne_u32 s[76:77], s65, v248
    v_cmp_ne_u32 s[78:79], s65, v250
    s_or_b64 vcc, s[76:77], s[78:79]
    s_cbranch_scc0 L_poutok
    s_add_u32 s3, s3, 1
    s_cmp_gt_u32 s3, 20000
    s_cbranch_scc1 L_poutok
    s_sleep 1
    s_branch L_poutpoll
L_poutok:
    v_and_b32 v212, s46, v212
    v_and_b32 v213, s46, v213
    v_and_b32 v214, s46, v214
    v_and_b32 v215, s46, v215
    v_and_b32 v216, s46, v216
    v_and_b32 v217, s46, v217
    v_and_b32 v218, s46, v218
    v_and_b32 v219, s46, v219
    v_pk_add_f32 v[212:213], v[212:213], v[216:217]
    v_pk_add_f32 v[214:215], v[214:215], v[218:219]
    s_nop 1
    v_permlane32_swap_b32 v212, v214
    v_permlane32_swap_b32 v213, v215
    v_add_f32 v212, v212, v214
    v_add_f32 v213, v213, v215
    s_nop 1
    v_permlane16_swap_b32 v212, v213
    v_add_f32 v212, v212, v213
    s_nop 1
    v_add_f32_dpp v212, v212, v212 row_ror:8 row_mask:0xf bank_mask:0xf
    s_nop 1
    v_add_f32_dpp v212, v212, v212 row_ror:4 row_mask:0xf bank_mask:0xf
    v_cvt_pk_bf16_f32 v212, v212, v212
    s_mov_b32 exec_lo, 0x000f000f
    s_mov_b32 exec_hi, 0x000f000f
    buffer_store_short v212, v13, s[48:51], 0 offen
    s_cmp_lg_u32 s2, 0
    s_cbranch_scc1 L_fin
    v_mov_b32 v14, s65
    v_mov_b32 v15, 0
    s_mov_b64 exec, 1
    buffer_store_dword v14, v15, s[36:39], 0 offen sc1
L_fin:
L_end:
    s_endpgm
.section .rodata,"a"
.p2align 6
.amdhsa_kernel gated_mix__compressed_kv_cla__dense_activation_mish__decode_kernel
  .amdhsa_next_free_vgpr 256
  .amdhsa_next_free_sgpr 102
  .amdhsa_accum_offset 256
  .amdhsa_group_segment_fixed_size 0
  .amdhsa_kernarg_size 112
  .amdhsa_user_sgpr_count 2
  .amdhsa_user_sgpr_kernarg_segment_ptr 1
  .amdhsa_system_sgpr_workgroup_id_x 1
.end_amdhsa_kernel
```
